```python
import torch

def _softmax(x, axis=-1):
    return torch.softmax(x, dim=axis)
def _gelu(x):
    return torch.nn.functional.gelu(x, approximate="tanh")
def _silu(x):
    return torch.nn.functional.silu(x)
def _sigmoid(x):
    return torch.sigmoid(x)
def _layernorm(x, axis=-1, eps=1e-5):
    m = x.mean(dim=axis, keepdim=True)
    v = x.var(dim=axis, keepdim=True, unbiased=False)
    return (x - m) / torch.sqrt(v + eps)
def _scatter_add(tgt, idx, src, axis=0):
    return tgt.clone().index_add_(axis, idx, src)
def _segment_sum(src, seg, n):
    out = torch.zeros((n,) + src.shape[1:], dtype=src.dtype)
    return out.index_add_(0, seg, src)
def _pad(x, pw):
    flat = tuple(v for pair in reversed(pw) for v in pair)
    return torch.nn.functional.pad(x, flat)

kernel_name = 'standalone__swiglu_ffn__sampling'

def setup_inputs():

    _w = (lambda a: (lambda t: t.to(torch.bfloat16) if t.is_floating_point() else t)(torch.as_tensor(a)))
    B, S, D, F = 16, 16, 1024, 3584
    return {
        "x": _w((lambda *s: torch.randn(*s, dtype=torch.bfloat16) * 0.05)(B, S, D)),
        "w_gate": _w((lambda *s: torch.randn(*s, dtype=torch.bfloat16) * 0.05)(D, F)),
        "w_up": _w((lambda *s: torch.randn(*s, dtype=torch.bfloat16) * 0.05)(D, F)),
        "w_down": _w((lambda *s: torch.randn(*s, dtype=torch.bfloat16) * 0.05)(F, D)),
    }

def reference(x, w_gate, w_up, w_down):
    g = _silu(x @ w_gate)
    u = x @ w_up
    return (g * u) @ w_down
```

```asm
; @launch kernel=standalone__swiglu_ffn__sampling_kernel grid=(224,1,1) block=(512,1,1) lds=147456
; @launch kernel=ffn_down_kernel grid=(256,1,1) block=(512,1,1) lds=98304
; @launch kernel=ffn_reduce_kernel grid=(256,1,1) block=(256,1,1) lds=0
.amdgcn_target "amdgcn-amd-amdhsa--gfx950"
.text
.globl standalone__swiglu_ffn__sampling_kernel
.p2align 8
.type standalone__swiglu_ffn__sampling_kernel,@function
standalone__swiglu_ffn__sampling_kernel:
    s_cmp_ge_u32 s2, 224
    s_cbranch_scc1 standalone__swiglu_ffn__sampling_kernel_done
    s_load_dwordx4 s[28:31], s[0:1], 0
    s_load_dwordx4 s[32:35], s[0:1], 16
    s_load_dwordx4 s[36:39], s[0:1], 32
    s_load_dwordx2 s[40:41], s[0:1], 48
    v_and_b32 v1, 63, v0
    v_lshrrev_b32 v2, 6, v0
    s_nop 0
    v_readfirstlane_b32 s42, v2
    s_and_b32 s43, s2, 7
    s_lshr_b32 s44, s2, 3
    s_and_b32 s45, s44, 3
    s_lshr_b32 s46, s44, 2
    s_lshl_b32 s46, s46, 3
    s_add_u32 s46, s46, s43
    s_waitcnt lgkmcnt(0)
    s_mov_b32 s8, s28
    s_and_b32 s9, s29, 0xffff
    s_mov_b32 s10, 524288
    s_mov_b32 s11, 0x20000
    s_mov_b32 s12, s30
    s_and_b32 s13, s31, 0xffff
    s_mov_b32 s14, 7340032
    s_mov_b32 s15, 0x20000
    s_mov_b32 s16, s32
    s_and_b32 s17, s33, 0xffff
    s_mov_b32 s18, 7340032
    s_mov_b32 s19, 0x20000
    s_add_u32 s20, s40, 0
    s_addc_u32 s21, s41, 0
    s_and_b32 s21, s21, 0xffff
    s_mov_b32 s22, 1835008
    s_mov_b32 s23, 0x20000
    v_and_b32 v2, 3, v2
    v_lshrrev_b32 v3, 3, v1
    v_lshl_add_u32 v3, v2, 4, v3
    v_and_b32 v4, 7, v1
    v_lshrrev_b32 v5, 4, v1
    v_xor_b32 v6, v4, v5
    v_xor_b32 v7, 4, v6
    s_lshl_b32 s48, s45, 6
    v_add_u32 v8, s48, v3
    s_mov_b32 s49, 2048
    v_mul_lo_u32 v8, v8, s49
    v_add_u32 v9, 16384, v8
    v_lshl_add_u32 v8, v6, 4, v8
    v_lshl_add_u32 v9, v7, 4, v9
    v_lshrrev_b32 v10, 1, v4
    v_and_b32 v11, 2, v3
    v_xor_b32 v10, v10, v11
    v_lshlrev_b32 v10, 5, v10
    v_and_b32 v11, 1, v4
    v_lshl_add_u32 v10, v11, 4, v10
    s_mov_b32 s49, 7168
    v_mul_lo_u32 v11, v3, s49
    v_add_u32 v10, v10, v11
    s_lshl_b32 s48, s46, 7
    v_add_u32 v10, s48, v10
    v_add_u32 v11, 57344, v10
    s_mov_b32 s24, 0
    s_mov_b32 s25, 0
    s_and_b32 s26, s42, 3
    s_lshl_b32 s26, s26, 11
    s_cmp_ge_u32 s42, 4
    s_cbranch_scc1 standalone__swiglu_ffn__sampling_kernel_loader
    v_lshrrev_b32 v3, 1, v2
    v_and_b32 v4, 31, v1
    v_lshl_add_u32 v3, v3, 5, v4
    v_lshrrev_b32 v4, 1, v3
    v_and_b32 v4, 7, v4
    v_lshrrev_b32 v5, 5, v1
    v_xor_b32 v4, v4, v5
    v_lshlrev_b32 v5, 7, v3
    v_xor_b32 v6, 0, v4
    v_lshl_add_u32 v12, v6, 4, v5
    v_add_u32 v12, 98304, v12
    v_xor_b32 v6, 2, v4
    v_lshl_add_u32 v13, v6, 4, v5
    v_add_u32 v13, 98304, v13
    v_xor_b32 v6, 4, v4
    v_lshl_add_u32 v14, v6, 4, v5
    v_add_u32 v14, 98304, v14
    v_xor_b32 v6, 6, v4
    v_lshl_add_u32 v15, v6, 4, v5
    v_add_u32 v15, 98304, v15
    v_lshrrev_b32 v3, 4, v1
    v_lshrrev_b32 v4, 2, v1
    v_and_b32 v4, 3, v4
    v_and_b32 v5, 3, v1
    v_and_b32 v6, 1, v2
    v_and_b32 v7, 1, v3
    v_lshl_add_u32 v6, v6, 1, v7
    v_and_b32 v7, 2, v4
    v_xor_b32 v6, v6, v7
    v_lshrrev_b32 v3, 1, v3
    v_lshl_add_u32 v3, v3, 3, v4
    v_lshlrev_b32 v3, 7, v3
    v_lshl_add_u32 v3, v6, 5, v3
    v_lshl_add_u32 v16, v5, 3, v3
    v_mov_b32 v72, 0
    v_mov_b32 v73, 0
    v_mov_b32 v74, 0
    v_mov_b32 v75, 0
    v_mov_b32 v76, 0
    v_mov_b32 v77, 0
    v_mov_b32 v78, 0
    v_mov_b32 v79, 0
    v_mov_b32 v80, 0
    v_mov_b32 v81, 0
    v_mov_b32 v82, 0
    v_mov_b32 v83, 0
    v_mov_b32 v84, 0
    v_mov_b32 v85, 0
    v_mov_b32 v86, 0
    v_mov_b32 v87, 0
    v_mov_b32 v88, 0
    v_mov_b32 v89, 0
    v_mov_b32 v90, 0
    v_mov_b32 v91, 0
    v_mov_b32 v92, 0
    v_mov_b32 v93, 0
    v_mov_b32 v94, 0
    v_mov_b32 v95, 0
    v_mov_b32 v96, 0
    v_mov_b32 v97, 0
    v_mov_b32 v98, 0
    v_mov_b32 v99, 0
    v_mov_b32 v100, 0
    v_mov_b32 v101, 0
    v_mov_b32 v102, 0
    v_mov_b32 v103, 0
    s_mov_b32 s60, 0
    s_mov_b32 s63, 16384
    s_mov_b32 s64, 0
    s_mov_b32 s65, 8192
    s_mov_b32 s61, 15
    s_barrier
    ds_read_b128 v[20:23], v12
    ds_read_b64_tr_b16 v[24:25], v16 offset:0
    ds_read_b64_tr_b16 v[26:27], v16 offset:512
    ds_read_b64_tr_b16 v[28:29], v16 offset:8192
    ds_read_b64_tr_b16 v[30:31], v16 offset:8704
    ds_read_b128 v[32:35], v13
    ds_read_b64_tr_b16 v[36:37], v16 offset:2048
    ds_read_b64_tr_b16 v[38:39], v16 offset:2560
    ds_read_b64_tr_b16 v[40:41], v16 offset:10240
    ds_read_b64_tr_b16 v[42:43], v16 offset:10752
standalone__swiglu_ffn__sampling_kernel_kloop:
    ds_read_b128 v[44:47], v14
    ds_read_b64_tr_b16 v[48:49], v16 offset:4096
    ds_read_b64_tr_b16 v[50:51], v16 offset:4608
    ds_read_b64_tr_b16 v[52:53], v16 offset:12288
    ds_read_b64_tr_b16 v[54:55], v16 offset:12800
    s_waitcnt lgkmcnt(10)
    v_mfma_f32_32x32x16_bf16 v[72:87], v[24:27], v[20:23], v[72:87]
    v_mfma_f32_32x32x16_bf16 v[88:103], v[28:31], v[20:23], v[88:103]
    ds_read_b128 v[56:59], v15
    ds_read_b64_tr_b16 v[60:61], v16 offset:6144
    ds_read_b64_tr_b16 v[62:63], v16 offset:6656
    ds_read_b64_tr_b16 v[64:65], v16 offset:14336
    ds_read_b64_tr_b16 v[66:67], v16 offset:14848
    s_waitcnt lgkmcnt(10)
    v_mfma_f32_32x32x16_bf16 v[72:87], v[36:39], v[32:35], v[72:87]
    v_mfma_f32_32x32x16_bf16 v[88:103], v[40:43], v[32:35], v[88:103]
    s_cmp_eq_u32 s60, 5
    s_cselect_b32 s62, -81920, s63
    s_add_u32 s60, s60, 1
    s_cmp_eq_u32 s60, 6
    s_cselect_b32 s60, 0, s60
    v_add_u32 v16, s62, v16
    s_cmp_eq_u32 s64, 5
    s_cselect_b32 s62, -40960, s65
    s_add_u32 s64, s64, 1
    s_cmp_eq_u32 s64, 6
    s_cselect_b32 s64, 0, s64
    v_add_u32 v12, s62, v12
    v_add_u32 v13, s62, v13
    v_add_u32 v14, s62, v14
    v_add_u32 v15, s62, v15
    s_barrier
    ds_read_b128 v[20:23], v12
    ds_read_b64_tr_b16 v[24:25], v16 offset:0
    ds_read_b64_tr_b16 v[26:27], v16 offset:512
    ds_read_b64_tr_b16 v[28:29], v16 offset:8192
    ds_read_b64_tr_b16 v[30:31], v16 offset:8704
    s_waitcnt lgkmcnt(10)
    v_mfma_f32_32x32x16_bf16 v[72:87], v[48:51], v[44:47], v[72:87]
    v_mfma_f32_32x32x16_bf16 v[88:103], v[52:55], v[44:47], v[88:103]
    ds_read_b128 v[32:35], v13
    ds_read_b64_tr_b16 v[36:37], v16 offset:2048
    ds_read_b64_tr_b16 v[38:39], v16 offset:2560
    ds_read_b64_tr_b16 v[40:41], v16 offset:10240
    ds_read_b64_tr_b16 v[42:43], v16 offset:10752
    s_waitcnt lgkmcnt(10)
    v_mfma_f32_32x32x16_bf16 v[72:87], v[60:63], v[56:59], v[72:87]
    v_mfma_f32_32x32x16_bf16 v[88:103], v[64:67], v[56:59], v[88:103]
    s_sub_u32 s61, s61, 1
    s_cmp_lg_u32 s61, 0
    s_cbranch_scc1 standalone__swiglu_ffn__sampling_kernel_kloop
    ds_read_b128 v[44:47], v14
    ds_read_b64_tr_b16 v[48:49], v16 offset:4096
    ds_read_b64_tr_b16 v[50:51], v16 offset:4608
    ds_read_b64_tr_b16 v[52:53], v16 offset:12288
    ds_read_b64_tr_b16 v[54:55], v16 offset:12800
    s_waitcnt lgkmcnt(10)
    v_mfma_f32_32x32x16_bf16 v[72:87], v[24:27], v[20:23], v[72:87]
    v_mfma_f32_32x32x16_bf16 v[88:103], v[28:31], v[20:23], v[88:103]
    ds_read_b128 v[56:59], v15
    ds_read_b64_tr_b16 v[60:61], v16 offset:6144
    ds_read_b64_tr_b16 v[62:63], v16 offset:6656
    ds_read_b64_tr_b16 v[64:65], v16 offset:14336
    ds_read_b64_tr_b16 v[66:67], v16 offset:14848
    s_waitcnt lgkmcnt(10)
    v_mfma_f32_32x32x16_bf16 v[72:87], v[36:39], v[32:35], v[72:87]
    v_mfma_f32_32x32x16_bf16 v[88:103], v[40:43], v[32:35], v[88:103]
    s_waitcnt lgkmcnt(5)
    v_mfma_f32_32x32x16_bf16 v[72:87], v[48:51], v[44:47], v[72:87]
    v_mfma_f32_32x32x16_bf16 v[88:103], v[52:55], v[44:47], v[88:103]
    s_waitcnt lgkmcnt(0)
    v_mfma_f32_32x32x16_bf16 v[72:87], v[60:63], v[56:59], v[72:87]
    v_mfma_f32_32x32x16_bf16 v[88:103], v[64:67], v[56:59], v[88:103]
    s_nop 15
    s_nop 7
    v_lshrrev_b32 v3, 1, v2
    v_and_b32 v4, 31, v1
    v_lshl_add_u32 v3, v3, 5, v4
    s_lshl_b32 s48, s45, 6
    v_add_u32 v3, s48, v3
    v_and_b32 v4, 1, v2
    v_lshlrev_b32 v4, 5, v4
    v_lshrrev_b32 v5, 5, v1
    v_lshl_add_u32 v4, v5, 2, v4
    s_lshl_b32 s48, s46, 6
    v_add_u32 v4, s48, v4
    s_mov_b32 s49, 7168
    v_mul_lo_u32 v3, v3, s49
    v_lshl_add_u32 v3, v4, 1, v3
    s_mov_b32 s49, 0xffff0000
    s_mov_b32 s50, 0xbfb8aa3b
    v_cvt_pk_bf16_f32 v20, v72, v73
    v_cvt_pk_bf16_f32 v21, v88, v89
    v_lshlrev_b32 v22, 16, v20
    v_and_b32 v23, s49, v20
    v_lshlrev_b32 v24, 16, v21
    v_and_b32 v25, s49, v21
    v_mul_f32 v26, s50, v22
    v_mul_f32 v27, s50, v23
    v_exp_f32 v26, v26
    v_exp_f32 v27, v27
    s_nop 0
    v_add_f32 v26, 1.0, v26
    v_add_f32 v27, 1.0, v27
    v_rcp_f32 v26, v26
    v_rcp_f32 v27, v27
    s_nop 0
    v_mul_f32 v26, v22, v26
    v_mul_f32 v27, v23, v27
    v_cvt_pk_bf16_f32 v28, v26, v27
    v_lshlrev_b32 v26, 16, v28
    v_and_b32 v27, s49, v28
    v_mul_f32 v26, v26, v24
    v_mul_f32 v27, v27, v25
    v_cvt_pk_bf16_f32 v30, v26, v27
    v_cvt_pk_bf16_f32 v20, v74, v75
    v_cvt_pk_bf16_f32 v21, v90, v91
    v_lshlrev_b32 v22, 16, v20
    v_and_b32 v23, s49, v20
    v_lshlrev_b32 v24, 16, v21
    v_and_b32 v25, s49, v21
    v_mul_f32 v26, s50, v22
    v_mul_f32 v27, s50, v23
    v_exp_f32 v26, v26
    v_exp_f32 v27, v27
    s_nop 0
    v_add_f32 v26, 1.0, v26
    v_add_f32 v27, 1.0, v27
    v_rcp_f32 v26, v26
    v_rcp_f32 v27, v27
    s_nop 0
    v_mul_f32 v26, v22, v26
    v_mul_f32 v27, v23, v27
    v_cvt_pk_bf16_f32 v28, v26, v27
    v_lshlrev_b32 v26, 16, v28
    v_and_b32 v27, s49, v28
    v_mul_f32 v26, v26, v24
    v_mul_f32 v27, v27, v25
    v_cvt_pk_bf16_f32 v31, v26, v27
    buffer_store_dwordx2 v[30:31], v3, s[20:23], 0 offen offset:0
    v_cvt_pk_bf16_f32 v20, v76, v77
    v_cvt_pk_bf16_f32 v21, v92, v93
    v_lshlrev_b32 v22, 16, v20
    v_and_b32 v23, s49, v20
    v_lshlrev_b32 v24, 16, v21
    v_and_b32 v25, s49, v21
    v_mul_f32 v26, s50, v22
    v_mul_f32 v27, s50, v23
    v_exp_f32 v26, v26
    v_exp_f32 v27, v27
    s_nop 0
    v_add_f32 v26, 1.0, v26
    v_add_f32 v27, 1.0, v27
    v_rcp_f32 v26, v26
    v_rcp_f32 v27, v27
    s_nop 0
    v_mul_f32 v26, v22, v26
    v_mul_f32 v27, v23, v27
    v_cvt_pk_bf16_f32 v28, v26, v27
    v_lshlrev_b32 v26, 16, v28
    v_and_b32 v27, s49, v28
    v_mul_f32 v26, v26, v24
    v_mul_f32 v27, v27, v25
    v_cvt_pk_bf16_f32 v32, v26, v27
    v_cvt_pk_bf16_f32 v20, v78, v79
    v_cvt_pk_bf16_f32 v21, v94, v95
    v_lshlrev_b32 v22, 16, v20
    v_and_b32 v23, s49, v20
    v_lshlrev_b32 v24, 16, v21
    v_and_b32 v25, s49, v21
    v_mul_f32 v26, s50, v22
    v_mul_f32 v27, s50, v23
    v_exp_f32 v26, v26
    v_exp_f32 v27, v27
    s_nop 0
    v_add_f32 v26, 1.0, v26
    v_add_f32 v27, 1.0, v27
    v_rcp_f32 v26, v26
    v_rcp_f32 v27, v27
    s_nop 0
    v_mul_f32 v26, v22, v26
    v_mul_f32 v27, v23, v27
    v_cvt_pk_bf16_f32 v28, v26, v27
    v_lshlrev_b32 v26, 16, v28
    v_and_b32 v27, s49, v28
    v_mul_f32 v26, v26, v24
    v_mul_f32 v27, v27, v25
    v_cvt_pk_bf16_f32 v33, v26, v27
    buffer_store_dwordx2 v[32:33], v3, s[20:23], 0 offen offset:16
    v_cvt_pk_bf16_f32 v20, v80, v81
    v_cvt_pk_bf16_f32 v21, v96, v97
    v_lshlrev_b32 v22, 16, v20
    v_and_b32 v23, s49, v20
    v_lshlrev_b32 v24, 16, v21
    v_and_b32 v25, s49, v21
    v_mul_f32 v26, s50, v22
    v_mul_f32 v27, s50, v23
    v_exp_f32 v26, v26
    v_exp_f32 v27, v27
    s_nop 0
    v_add_f32 v26, 1.0, v26
    v_add_f32 v27, 1.0, v27
    v_rcp_f32 v26, v26
    v_rcp_f32 v27, v27
    s_nop 0
    v_mul_f32 v26, v22, v26
    v_mul_f32 v27, v23, v27
    v_cvt_pk_bf16_f32 v28, v26, v27
    v_lshlrev_b32 v26, 16, v28
    v_and_b32 v27, s49, v28
    v_mul_f32 v26, v26, v24
    v_mul_f32 v27, v27, v25
    v_cvt_pk_bf16_f32 v30, v26, v27
    v_cvt_pk_bf16_f32 v20, v82, v83
    v_cvt_pk_bf16_f32 v21, v98, v99
    v_lshlrev_b32 v22, 16, v20
    v_and_b32 v23, s49, v20
    v_lshlrev_b32 v24, 16, v21
    v_and_b32 v25, s49, v21
    v_mul_f32 v26, s50, v22
    v_mul_f32 v27, s50, v23
    v_exp_f32 v26, v26
    v_exp_f32 v27, v27
    s_nop 0
    v_add_f32 v26, 1.0, v26
    v_add_f32 v27, 1.0, v27
    v_rcp_f32 v26, v26
    v_rcp_f32 v27, v27
    s_nop 0
    v_mul_f32 v26, v22, v26
    v_mul_f32 v27, v23, v27
    v_cvt_pk_bf16_f32 v28, v26, v27
    v_lshlrev_b32 v26, 16, v28
    v_and_b32 v27, s49, v28
    v_mul_f32 v26, v26, v24
    v_mul_f32 v27, v27, v25
    v_cvt_pk_bf16_f32 v31, v26, v27
    buffer_store_dwordx2 v[30:31], v3, s[20:23], 0 offen offset:32
    v_cvt_pk_bf16_f32 v20, v84, v85
    v_cvt_pk_bf16_f32 v21, v100, v101
    v_lshlrev_b32 v22, 16, v20
    v_and_b32 v23, s49, v20
    v_lshlrev_b32 v24, 16, v21
    v_and_b32 v25, s49, v21
    v_mul_f32 v26, s50, v22
    v_mul_f32 v27, s50, v23
    v_exp_f32 v26, v26
    v_exp_f32 v27, v27
    s_nop 0
    v_add_f32 v26, 1.0, v26
    v_add_f32 v27, 1.0, v27
    v_rcp_f32 v26, v26
    v_rcp_f32 v27, v27
    s_nop 0
    v_mul_f32 v26, v22, v26
    v_mul_f32 v27, v23, v27
    v_cvt_pk_bf16_f32 v28, v26, v27
    v_lshlrev_b32 v26, 16, v28
    v_and_b32 v27, s49, v28
    v_mul_f32 v26, v26, v24
    v_mul_f32 v27, v27, v25
    v_cvt_pk_bf16_f32 v32, v26, v27
    v_cvt_pk_bf16_f32 v20, v86, v87
    v_cvt_pk_bf16_f32 v21, v102, v103
    v_lshlrev_b32 v22, 16, v20
    v_and_b32 v23, s49, v20
    v_lshlrev_b32 v24, 16, v21
    v_and_b32 v25, s49, v21
    v_mul_f32 v26, s50, v22
    v_mul_f32 v27, s50, v23
    v_exp_f32 v26, v26
    v_exp_f32 v27, v27
    s_nop 0
    v_add_f32 v26, 1.0, v26
    v_add_f32 v27, 1.0, v27
    v_rcp_f32 v26, v26
    v_rcp_f32 v27, v27
    s_nop 0
    v_mul_f32 v26, v22, v26
    v_mul_f32 v27, v23, v27
    v_cvt_pk_bf16_f32 v28, v26, v27
    v_lshlrev_b32 v26, 16, v28
    v_and_b32 v27, s49, v28
    v_mul_f32 v26, v26, v24
    v_mul_f32 v27, v27, v25
    v_cvt_pk_bf16_f32 v33, v26, v27
    buffer_store_dwordx2 v[32:33], v3, s[20:23], 0 offen offset:48
    s_waitcnt vmcnt(0)
    s_endpgm
standalone__swiglu_ffn__sampling_kernel_loader:
    v_lshlrev_b32 v17, 4, v1
    s_mov_b32 s56, s24
    s_mov_b32 s57, s25
    s_mul_i32 s27, s45, 4
    s_lshr_b32 s48, s2, 5
    s_add_u32 s27, s27, s48
    s_cmp_ge_u32 s27, 16
    s_cselect_b32 s48, 16, 0
    s_sub_u32 s27, s27, s48
    s_lshl_b32 s24, s27, 7
    s_add_u32 s24, s24, s56
    s_mul_i32 s25, s27, 458752
    s_add_u32 s25, s25, s57
    v_add_u32 v17, s26, v17
    v_add_u32 v18, 49152, v17
    s_mov_b32 s70, 0
    s_mov_b32 s71, 0
    s_mov_b32 s73, 3
standalone__swiglu_ffn__sampling_kernel_lpro:
    s_add_u32 s72, s26, s70
    s_add_u32 m0, s72, 98304
    s_nop 0
    buffer_load_dwordx4 v8, s[8:11], s24 offen lds
    s_add_u32 m0, s72, 99328
    s_nop 0
    buffer_load_dwordx4 v9, s[8:11], s24 offen lds
    s_add_u32 s72, s26, s71
    s_add_u32 m0, s72, 0
    s_nop 0
    buffer_load_dwordx4 v10, s[12:15], s25 offen lds
    s_add_u32 m0, s72, 1024
    s_nop 0
    buffer_load_dwordx4 v11, s[12:15], s25 offen lds
    s_add_u32 m0, s72, 8192
    s_nop 0
    buffer_load_dwordx4 v10, s[16:19], s25 offen lds
    s_add_u32 m0, s72, 9216
    s_nop 0
    buffer_load_dwordx4 v11, s[16:19], s25 offen lds
    s_add_u32 s70, s70, 8192
    s_cmp_eq_u32 s70, 49152
    s_cselect_b32 s70, 0, s70
    s_add_u32 s71, s71, 16384
    s_cmp_eq_u32 s71, 98304
    s_cselect_b32 s71, 0, s71
    s_add_u32 s27, s27, 1
    s_cmp_eq_u32 s27, 16
    s_cselect_b32 s27, 0, s27
    s_lshl_b32 s24, s27, 7
    s_add_u32 s24, s24, s56
    s_mul_i32 s25, s27, 458752
    s_add_u32 s25, s25, s57
    s_sub_u32 s73, s73, 1
    s_cmp_lg_u32 s73, 0
    s_cbranch_scc1 standalone__swiglu_ffn__sampling_kernel_lpro
    s_mov_b32 s73, 13
standalone__swiglu_ffn__sampling_kernel_lloop:
    s_waitcnt vmcnt(12)
    s_barrier
    s_add_u32 s72, s26, s70
    s_add_u32 m0, s72, 98304
    s_nop 0
    buffer_load_dwordx4 v8, s[8:11], s24 offen lds
    s_add_u32 m0, s72, 99328
    s_nop 0
    buffer_load_dwordx4 v9, s[8:11], s24 offen lds
    s_add_u32 s72, s26, s71
    s_add_u32 m0, s72, 0
    s_nop 0
    buffer_load_dwordx4 v10, s[12:15], s25 offen lds
    s_add_u32 m0, s72, 1024
    s_nop 0
    buffer_load_dwordx4 v11, s[12:15], s25 offen lds
    s_add_u32 m0, s72, 8192
    s_nop 0
    buffer_load_dwordx4 v10, s[16:19], s25 offen lds
    s_add_u32 m0, s72, 9216
    s_nop 0
    buffer_load_dwordx4 v11, s[16:19], s25 offen lds
    s_add_u32 s70, s70, 8192
    s_cmp_eq_u32 s70, 49152
    s_cselect_b32 s70, 0, s70
    s_add_u32 s71, s71, 16384
    s_cmp_eq_u32 s71, 98304
    s_cselect_b32 s71, 0, s71
    s_add_u32 s27, s27, 1
    s_cmp_eq_u32 s27, 16
    s_cselect_b32 s27, 0, s27
    s_lshl_b32 s24, s27, 7
    s_add_u32 s24, s24, s56
    s_mul_i32 s25, s27, 458752
    s_add_u32 s25, s25, s57
    s_sub_u32 s73, s73, 1
    s_cmp_lg_u32 s73, 0
    s_cbranch_scc1 standalone__swiglu_ffn__sampling_kernel_lloop
    s_mov_b32 s52, s34
    s_and_b32 s53, s35, 0xffff
    s_mov_b32 s54, 7340032
    s_mov_b32 s55, 0x20000
    s_lshl_b32 s48, s2, 2
    s_and_b32 s49, s42, 3
    s_add_u32 s48, s48, s49
    s_lshl_b32 s48, s48, 13
    v_lshlrev_b32 v19, 7, v1
    buffer_load_dword v19, v19, s[52:55], s48 offen
    s_waitcnt vmcnt(13)
    s_barrier
    s_waitcnt vmcnt(7)
    s_barrier
    s_waitcnt vmcnt(1)
    s_barrier
    s_endpgm
standalone__swiglu_ffn__sampling_kernel_done:
    s_endpgm
.globl ffn_down_kernel
.p2align 8
.type ffn_down_kernel,@function
ffn_down_kernel:
    s_cmp_ge_u32 s2, 256
    s_cbranch_scc1 ffn_down_kernel_done
    s_load_dwordx4 s[28:31], s[0:1], 0
    s_load_dwordx4 s[32:35], s[0:1], 16
    s_load_dwordx4 s[36:39], s[0:1], 32
    s_load_dwordx2 s[40:41], s[0:1], 48
    v_and_b32 v1, 63, v0
    v_lshrrev_b32 v2, 6, v0
    s_nop 0
    v_readfirstlane_b32 s42, v2
    s_and_b32 s43, s2, 7
    s_lshr_b32 s44, s2, 3
    s_and_b32 s45, s44, 3
    s_lshr_b32 s46, s44, 2
    s_and_b32 s47, s43, 1
    s_lshl_b32 s47, s47, 3
    s_add_u32 s46, s46, s47
    s_lshr_b32 s47, s43, 1
    s_waitcnt lgkmcnt(0)
    s_add_u32 s8, s40, 0
    s_addc_u32 s9, s41, 0
    s_and_b32 s9, s9, 0xffff
    s_mov_b32 s10, 1835008
    s_mov_b32 s11, 0x20000
    s_mov_b32 s12, s34
    s_and_b32 s13, s35, 0xffff
    s_mov_b32 s14, 7340032
    s_mov_b32 s15, 0x20000
    s_add_u32 s20, s40, 2097152
    s_addc_u32 s21, s41, 0
    s_and_b32 s21, s21, 0xffff
    s_mov_b32 s22, 4194304
    s_mov_b32 s23, 0x20000
    v_and_b32 v2, 3, v2
    v_lshrrev_b32 v3, 3, v1
    v_lshl_add_u32 v3, v2, 4, v3
    v_and_b32 v4, 7, v1
    v_lshrrev_b32 v5, 4, v1
    v_xor_b32 v6, v4, v5
    v_xor_b32 v7, 4, v6
    s_lshl_b32 s48, s45, 6
    v_add_u32 v8, s48, v3
    s_mov_b32 s49, 7168
    v_mul_lo_u32 v8, v8, s49
    v_add_u32 v9, 57344, v8
    v_lshl_add_u32 v8, v6, 4, v8
    v_lshl_add_u32 v9, v7, 4, v9
    v_lshrrev_b32 v10, 1, v4
    v_and_b32 v11, 2, v3
    v_xor_b32 v10, v10, v11
    v_lshlrev_b32 v10, 5, v10
    v_and_b32 v11, 1, v4
    v_lshl_add_u32 v10, v11, 4, v10
    s_mov_b32 s49, 2048
    v_mul_lo_u32 v11, v3, s49
    v_add_u32 v10, v10, v11
    s_lshl_b32 s48, s46, 7
    v_add_u32 v10, s48, v10
    v_add_u32 v11, 16384, v10
    s_mul_i32 s24, s47, 1792
    s_mul_i32 s25, s47, 1835008
    s_and_b32 s26, s42, 3
    s_lshl_b32 s26, s26, 11
    s_cmp_ge_u32 s42, 4
    s_cbranch_scc1 ffn_down_kernel_loader
    v_lshrrev_b32 v3, 1, v2
    v_and_b32 v4, 31, v1
    v_lshl_add_u32 v3, v3, 5, v4
    v_lshrrev_b32 v4, 1, v3
    v_and_b32 v4, 7, v4
    v_lshrrev_b32 v5, 5, v1
    v_xor_b32 v4, v4, v5
    v_lshlrev_b32 v5, 7, v3
    v_xor_b32 v6, 0, v4
    v_lshl_add_u32 v12, v6, 4, v5
    v_add_u32 v12, 49152, v12
    v_xor_b32 v6, 2, v4
    v_lshl_add_u32 v13, v6, 4, v5
    v_add_u32 v13, 49152, v13
    v_xor_b32 v6, 4, v4
    v_lshl_add_u32 v14, v6, 4, v5
    v_add_u32 v14, 49152, v14
    v_xor_b32 v6, 6, v4
    v_lshl_add_u32 v15, v6, 4, v5
    v_add_u32 v15, 49152, v15
    v_lshrrev_b32 v3, 4, v1
    v_lshrrev_b32 v4, 2, v1
    v_and_b32 v4, 3, v4
    v_and_b32 v5, 3, v1
    v_and_b32 v6, 1, v2
    v_and_b32 v7, 1, v3
    v_lshl_add_u32 v6, v6, 1, v7
    v_and_b32 v7, 2, v4
    v_xor_b32 v6, v6, v7
    v_lshrrev_b32 v3, 1, v3
    v_lshl_add_u32 v3, v3, 3, v4
    v_lshlrev_b32 v3, 7, v3
    v_lshl_add_u32 v3, v6, 5, v3
    v_lshl_add_u32 v16, v5, 3, v3
    v_mov_b32 v72, 0
    v_mov_b32 v73, 0
    v_mov_b32 v74, 0
    v_mov_b32 v75, 0
    v_mov_b32 v76, 0
    v_mov_b32 v77, 0
    v_mov_b32 v78, 0
    v_mov_b32 v79, 0
    v_mov_b32 v80, 0
    v_mov_b32 v81, 0
    v_mov_b32 v82, 0
    v_mov_b32 v83, 0
    v_mov_b32 v84, 0
    v_mov_b32 v85, 0
    v_mov_b32 v86, 0
    v_mov_b32 v87, 0
    s_mov_b32 s60, 0
    s_mov_b32 s63, 8192
    s_mov_b32 s64, 0
    s_mov_b32 s65, 8192
    s_mov_b32 s61, 13
    s_barrier
    ds_read_b128 v[20:23], v12
    ds_read_b64_tr_b16 v[24:25], v16 offset:0
    ds_read_b64_tr_b16 v[26:27], v16 offset:512
    ds_read_b128 v[28:31], v13
    ds_read_b64_tr_b16 v[32:33], v16 offset:2048
    ds_read_b64_tr_b16 v[34:35], v16 offset:2560
ffn_down_kernel_kloop:
    ds_read_b128 v[36:39], v14
    ds_read_b64_tr_b16 v[40:41], v16 offset:4096
    ds_read_b64_tr_b16 v[42:43], v16 offset:4608
    s_waitcnt lgkmcnt(6)
    v_mfma_f32_32x32x16_bf16 v[72:87], v[24:27], v[20:23], v[72:87]
    ds_read_b128 v[44:47], v15
    ds_read_b64_tr_b16 v[48:49], v16 offset:6144
    ds_read_b64_tr_b16 v[50:51], v16 offset:6656
    s_waitcnt lgkmcnt(6)
    v_mfma_f32_32x32x16_bf16 v[72:87], v[32:35], v[28:31], v[72:87]
    s_cmp_eq_u32 s60, 5
    s_cselect_b32 s62, -40960, s63
    s_add_u32 s60, s60, 1
    s_cmp_eq_u32 s60, 6
    s_cselect_b32 s60, 0, s60
    v_add_u32 v16, s62, v16
    s_cmp_eq_u32 s64, 5
    s_cselect_b32 s62, -40960, s65
    s_add_u32 s64, s64, 1
    s_cmp_eq_u32 s64, 6
    s_cselect_b32 s64, 0, s64
    v_add_u32 v12, s62, v12
    v_add_u32 v13, s62, v13
    v_add_u32 v14, s62, v14
    v_add_u32 v15, s62, v15
    s_barrier
    ds_read_b128 v[20:23], v12
    ds_read_b64_tr_b16 v[24:25], v16 offset:0
    ds_read_b64_tr_b16 v[26:27], v16 offset:512
    s_waitcnt lgkmcnt(6)
    v_mfma_f32_32x32x16_bf16 v[72:87], v[40:43], v[36:39], v[72:87]
    ds_read_b128 v[28:31], v13
    ds_read_b64_tr_b16 v[32:33], v16 offset:2048
    ds_read_b64_tr_b16 v[34:35], v16 offset:2560
    s_waitcnt lgkmcnt(6)
    v_mfma_f32_32x32x16_bf16 v[72:87], v[48:51], v[44:47], v[72:87]
    s_sub_u32 s61, s61, 1
    s_cmp_lg_u32 s61, 0
    s_cbranch_scc1 ffn_down_kernel_kloop
    ds_read_b128 v[36:39], v14
    ds_read_b64_tr_b16 v[40:41], v16 offset:4096
    ds_read_b64_tr_b16 v[42:43], v16 offset:4608
    s_waitcnt lgkmcnt(6)
    v_mfma_f32_32x32x16_bf16 v[72:87], v[24:27], v[20:23], v[72:87]
    ds_read_b128 v[44:47], v15
    ds_read_b64_tr_b16 v[48:49], v16 offset:6144
    ds_read_b64_tr_b16 v[50:51], v16 offset:6656
    s_waitcnt lgkmcnt(6)
    v_mfma_f32_32x32x16_bf16 v[72:87], v[32:35], v[28:31], v[72:87]
    s_waitcnt lgkmcnt(3)
    v_mfma_f32_32x32x16_bf16 v[72:87], v[40:43], v[36:39], v[72:87]
    s_waitcnt lgkmcnt(0)
    v_mfma_f32_32x32x16_bf16 v[72:87], v[48:51], v[44:47], v[72:87]
    s_nop 15
    s_nop 7
    v_lshrrev_b32 v3, 1, v2
    v_and_b32 v4, 31, v1
    v_lshl_add_u32 v3, v3, 5, v4
    s_lshl_b32 s48, s45, 6
    v_add_u32 v3, s48, v3
    v_and_b32 v4, 1, v2
    v_lshlrev_b32 v4, 5, v4
    v_lshrrev_b32 v5, 5, v1
    v_lshl_add_u32 v4, v5, 2, v4
    s_lshl_b32 s48, s46, 6
    v_add_u32 v4, s48, v4
    v_lshlrev_b32 v3, 12, v3
    v_lshl_add_u32 v3, v4, 2, v3
    s_mul_i32 s48, s47, 1048576
    v_add_u32 v3, s48, v3
    buffer_store_dwordx4 v[72:75], v3, s[20:23], 0 offen offset:0
    buffer_store_dwordx4 v[76:79], v3, s[20:23], 0 offen offset:32
    buffer_store_dwordx4 v[80:83], v3, s[20:23], 0 offen offset:64
    buffer_store_dwordx4 v[84:87], v3, s[20:23], 0 offen offset:96
    s_waitcnt vmcnt(0)
    s_endpgm
ffn_down_kernel_loader:
    v_lshlrev_b32 v17, 4, v1
    s_mov_b32 s56, s24
    s_mov_b32 s57, s25
    s_mul_i32 s27, s45, 3
    s_lshr_b32 s48, s2, 5
    s_add_u32 s27, s27, s48
    s_cmp_ge_u32 s27, 14
    s_cselect_b32 s48, 14, 0
    s_sub_u32 s27, s27, s48
    s_lshl_b32 s24, s27, 7
    s_add_u32 s24, s24, s56
    s_mul_i32 s25, s27, 131072
    s_add_u32 s25, s25, s57
    v_add_u32 v17, s26, v17
    v_add_u32 v18, 49152, v17
    s_mov_b32 s70, 0
    s_mov_b32 s71, 0
    s_mov_b32 s73, 3
ffn_down_kernel_lpro:
    s_add_u32 s72, s26, s70
    s_add_u32 m0, s72, 49152
    s_nop 0
    buffer_load_dwordx4 v8, s[8:11], s24 offen lds
    s_add_u32 m0, s72, 50176
    s_nop 0
    buffer_load_dwordx4 v9, s[8:11], s24 offen lds
    s_add_u32 s72, s26, s71
    s_add_u32 m0, s72, 0
    s_nop 0
    buffer_load_dwordx4 v10, s[12:15], s25 offen lds
    s_add_u32 m0, s72, 1024
    s_nop 0
    buffer_load_dwordx4 v11, s[12:15], s25 offen lds
    s_add_u32 s70, s70, 8192
    s_cmp_eq_u32 s70, 49152
    s_cselect_b32 s70, 0, s70
    s_add_u32 s71, s71, 8192
    s_cmp_eq_u32 s71, 49152
    s_cselect_b32 s71, 0, s71
    s_add_u32 s27, s27, 1
    s_cmp_eq_u32 s27, 14
    s_cselect_b32 s27, 0, s27
    s_lshl_b32 s24, s27, 7
    s_add_u32 s24, s24, s56
    s_mul_i32 s25, s27, 131072
    s_add_u32 s25, s25, s57
    s_sub_u32 s73, s73, 1
    s_cmp_lg_u32 s73, 0
    s_cbranch_scc1 ffn_down_kernel_lpro
    s_mov_b32 s73, 11
ffn_down_kernel_lloop:
    s_waitcnt vmcnt(8)
    s_barrier
    s_add_u32 s72, s26, s70
    s_add_u32 m0, s72, 49152
    s_nop 0
    buffer_load_dwordx4 v8, s[8:11], s24 offen lds
    s_add_u32 m0, s72, 50176
    s_nop 0
    buffer_load_dwordx4 v9, s[8:11], s24 offen lds
    s_add_u32 s72, s26, s71
    s_add_u32 m0, s72, 0
    s_nop 0
    buffer_load_dwordx4 v10, s[12:15], s25 offen lds
    s_add_u32 m0, s72, 1024
    s_nop 0
    buffer_load_dwordx4 v11, s[12:15], s25 offen lds
    s_add_u32 s70, s70, 8192
    s_cmp_eq_u32 s70, 49152
    s_cselect_b32 s70, 0, s70
    s_add_u32 s71, s71, 8192
    s_cmp_eq_u32 s71, 49152
    s_cselect_b32 s71, 0, s71
    s_add_u32 s27, s27, 1
    s_cmp_eq_u32 s27, 14
    s_cselect_b32 s27, 0, s27
    s_lshl_b32 s24, s27, 7
    s_add_u32 s24, s24, s56
    s_mul_i32 s25, s27, 131072
    s_add_u32 s25, s25, s57
    s_sub_u32 s73, s73, 1
    s_cmp_lg_u32 s73, 0
    s_cbranch_scc1 ffn_down_kernel_lloop
    s_waitcnt vmcnt(8)
    s_barrier
    s_waitcnt vmcnt(4)
    s_barrier
    s_waitcnt vmcnt(0)
    s_barrier
    s_endpgm
ffn_down_kernel_done:
    s_endpgm
.globl ffn_reduce_kernel
.p2align 8
.type ffn_reduce_kernel,@function
ffn_reduce_kernel:
    s_cmp_ge_u32 s2, 256
    s_cbranch_scc1 ffn_reduce_kernel_done
    s_load_dwordx2 s[36:37], s[0:1], 32
    s_load_dwordx2 s[40:41], s[0:1], 48
    s_lshl_b32 s3, s2, 8
    v_add_u32 v1, s3, v0
    v_lshlrev_b32 v2, 4, v1
    v_lshlrev_b32 v3, 3, v1
    s_waitcnt lgkmcnt(0)
    s_add_u32 s8, s40, 2097152
    s_addc_u32 s9, s41, 0
    s_and_b32 s9, s9, 0xffff
    s_mov_b32 s10, 4194304
    s_mov_b32 s11, 0x20000
    s_mov_b32 s12, s36
    s_and_b32 s13, s37, 0xffff
    s_mov_b32 s14, 524288
    s_mov_b32 s15, 0x20000
    s_mov_b32 s16, 0
    buffer_load_dwordx4 v[4:7], v2, s[8:11], s16 offen
    s_mov_b32 s16, 1048576
    buffer_load_dwordx4 v[8:11], v2, s[8:11], s16 offen
    s_mov_b32 s16, 2097152
    buffer_load_dwordx4 v[12:15], v2, s[8:11], s16 offen
    s_mov_b32 s16, 3145728
    buffer_load_dwordx4 v[16:19], v2, s[8:11], s16 offen
    s_waitcnt vmcnt(2)
    v_add_f32 v4, v4, v8
    v_add_f32 v5, v5, v9
    v_add_f32 v6, v6, v10
    v_add_f32 v7, v7, v11
    s_waitcnt vmcnt(1)
    v_add_f32 v4, v4, v12
    v_add_f32 v5, v5, v13
    v_add_f32 v6, v6, v14
    v_add_f32 v7, v7, v15
    s_waitcnt vmcnt(0)
    v_add_f32 v4, v4, v16
    v_add_f32 v5, v5, v17
    v_add_f32 v6, v6, v18
    v_add_f32 v7, v7, v19
    v_cvt_pk_bf16_f32 v20, v4, v5
    v_cvt_pk_bf16_f32 v21, v6, v7
    buffer_store_dwordx2 v[20:21], v3, s[12:15], 0 offen
    s_waitcnt vmcnt(0)
ffn_reduce_kernel_done:
    s_endpgm
.section .rodata,"a"
.p2align 6
.amdhsa_kernel standalone__swiglu_ffn__sampling_kernel
  .amdhsa_next_free_vgpr 128
  .amdhsa_next_free_sgpr 102
  .amdhsa_accum_offset 128
  .amdhsa_group_segment_fixed_size 0
  .amdhsa_kernarg_size 56
  .amdhsa_user_sgpr_count 2
  .amdhsa_user_sgpr_kernarg_segment_ptr 1
  .amdhsa_system_sgpr_workgroup_id_x 1
.end_amdhsa_kernel
.p2align 6
.amdhsa_kernel ffn_down_kernel
  .amdhsa_next_free_vgpr 128
  .amdhsa_next_free_sgpr 102
  .amdhsa_accum_offset 128
  .amdhsa_group_segment_fixed_size 0
  .amdhsa_kernarg_size 56
  .amdhsa_user_sgpr_count 2
  .amdhsa_user_sgpr_kernarg_segment_ptr 1
  .amdhsa_system_sgpr_workgroup_id_x 1
.end_amdhsa_kernel
.p2align 6
.amdhsa_kernel ffn_reduce_kernel
  .amdhsa_next_free_vgpr 24
  .amdhsa_next_free_sgpr 102
  .amdhsa_accum_offset 24
  .amdhsa_group_segment_fixed_size 0
  .amdhsa_kernarg_size 56
  .amdhsa_user_sgpr_count 2
  .amdhsa_user_sgpr_kernarg_segment_ptr 1
  .amdhsa_system_sgpr_workgroup_id_x 1
.end_amdhsa_kernel
```
